```python
import torch

def _softmax(x, axis=-1):
    return torch.softmax(x, dim=axis)
def _gelu(x):
    return torch.nn.functional.gelu(x, approximate="tanh")
def _silu(x):
    return torch.nn.functional.silu(x)
def _sigmoid(x):
    return torch.sigmoid(x)
def _layernorm(x, axis=-1, eps=1e-5):
    m = x.mean(dim=axis, keepdim=True)
    v = x.var(dim=axis, keepdim=True, unbiased=False)
    return (x - m) / torch.sqrt(v + eps)
def _scatter_add(tgt, idx, src, axis=0):
    return tgt.clone().index_add_(axis, idx, src)
def _segment_sum(src, seg, n):
    out = torch.zeros((n,) + src.shape[1:], dtype=src.dtype)
    return out.index_add_(0, seg, src)
def _pad(x, pw):
    flat = tuple(v for pair in reversed(pw) for v in pair)
    return torch.nn.functional.pad(x, flat)

kernel_name = 'concat_heads__gqa_block_cached__gqa_block_cached__decode'

def setup_inputs():

    _w = (lambda a: (lambda t: t.to(torch.bfloat16) if t.is_floating_point() else t)(torch.as_tensor(a)))
    def _A_setup():
        B, Sq, D = 1, 1, 576
        Hq, Hkv, Sk, Dh = 32, 16, 8192, 128
        assert Hq % Hkv == 0, (Hq, Hkv)
        return {
            "x": _w((lambda *s: torch.randn(*s, dtype=torch.bfloat16) * 0.8)(B, Sq, D)),
            "k_cache": _w((lambda *s: torch.randn(*s, dtype=torch.bfloat16) * 0.8)(B, Hkv, Sk, Dh)),
            "v_cache": _w((lambda *s: torch.randn(*s, dtype=torch.bfloat16) * 0.05)(B, Hkv, Sk, Dh)),
            "wq": _w((lambda *s: torch.randn(*s, dtype=torch.bfloat16) * 0.8)(D, Hq * Dh) * (D ** -0.5)),
            "wo": _w((lambda *s: torch.randn(*s, dtype=torch.bfloat16) * 0.05)(Hq * Dh, D) * ((Hq * Dh) ** -0.5)),
        }
    _A_in = _A_setup()

    def _B_setup():
        B, Sq, D = 1, 1, 576
        Hq, Hkv, Sk, Dh = 32, 16, 8192, 128
        assert Hq % Hkv == 0, (Hq, Hkv)
        return {
            "x": _w((lambda *s: torch.randn(*s, dtype=torch.bfloat16) * 0.8)(B, Sq, D)),
            "k_cache": _w((lambda *s: torch.randn(*s, dtype=torch.bfloat16) * 0.8)(B, Hkv, Sk, Dh)),
            "v_cache": _w((lambda *s: torch.randn(*s, dtype=torch.bfloat16) * 0.05)(B, Hkv, Sk, Dh)),
            "wq": _w((lambda *s: torch.randn(*s, dtype=torch.bfloat16) * 0.8)(D, Hq * Dh) * (D ** -0.5)),
            "wo": _w((lambda *s: torch.randn(*s, dtype=torch.bfloat16) * 0.05)(Hq * Dh, D) * ((Hq * Dh) ** -0.5)),
        }
    _B_in = _B_setup()

    return {
        "A_x": _A_in["x"],
        "A_k_cache": _A_in["k_cache"],
        "A_v_cache": _A_in["v_cache"],
        "A_wq": _A_in["wq"],
        "A_wo": _A_in["wo"],
        "B_x": _B_in["x"],
        "B_k_cache": _B_in["k_cache"],
        "B_v_cache": _B_in["v_cache"],
        "B_wq": _B_in["wq"],
        "B_wo": _B_in["wo"],
    }

def reference(A_x, A_k_cache, A_v_cache, A_wq, A_wo, B_x, B_k_cache, B_v_cache, B_wq, B_wo):
    def _A_ref(x, k_cache, v_cache, wq, wo):
        B, Sq, D = x.shape
        Hq, Dh = 32, 128
        Hkv = k_cache.shape[1]
        rep = Hq // Hkv
        q = (lambda x, *d: x.permute(*d))((x @ wq).reshape(B, Sq, Hq, Dh), 0, 2, 1, 3)
        k = (lambda x, n, axis: torch.repeat_interleave(x, n, dim=axis))(k_cache, rep, axis=1)
        v = (lambda x, n, axis: torch.repeat_interleave(x, n, dim=axis))(v_cache, rep, axis=1)
        scores = torch.einsum("bhqd,bhkd->bhqk", q, k) * (Dh ** -0.5)
        p = _softmax(scores, axis=-1)
        o = torch.einsum("bhqk,bhkd->bhqd", p, v)
        return (lambda x, *d: x.permute(*d))(o, 0, 2, 1, 3).reshape(B, Sq, Hq * Dh) @ wo

    def _B_ref(x, k_cache, v_cache, wq, wo):
        B, Sq, D = x.shape
        Hq, Dh = 32, 128
        Hkv = k_cache.shape[1]
        rep = Hq // Hkv
        q = (lambda x, *d: x.permute(*d))((x @ wq).reshape(B, Sq, Hq, Dh), 0, 2, 1, 3)
        k = (lambda x, n, axis: torch.repeat_interleave(x, n, dim=axis))(k_cache, rep, axis=1)
        v = (lambda x, n, axis: torch.repeat_interleave(x, n, dim=axis))(v_cache, rep, axis=1)
        scores = torch.einsum("bhqd,bhkd->bhqk", q, k) * (Dh ** -0.5)
        p = _softmax(scores, axis=-1)
        o = torch.einsum("bhqk,bhkd->bhqd", p, v)
        return (lambda x, *d: x.permute(*d))(o, 0, 2, 1, 3).reshape(B, Sq, Hq * Dh) @ wo

    a = _A_ref(A_x, A_k_cache, A_v_cache, A_wq, A_wo)
    b = _B_ref(B_x, B_k_cache, B_v_cache, B_wq, B_wo)
    return torch.concatenate([a, b], axis=-1)
```

```asm
; @launch grid=(256,1,1) block=(512,1,1) lds=11264
.amdgcn_target "amdgcn-amd-amdhsa--gfx950"
.text
.globl concat_heads__gqa_block_cached__gqa_block_cached__decode_kernel
.p2align 8
.type concat_heads__gqa_block_cached__gqa_block_cached__decode_kernel,@function
concat_heads__gqa_block_cached__gqa_block_cached__decode_kernel:
  s_lshr_b32 s10, s2, 8
  s_cbranch_scc1 L_end
  s_bitcmp1_b32 s2, 2
  s_cselect_b32 s3, 40, 0
  s_load_dwordx2 s[20:21], s[0:1], s3 offset:24
  s_load_dwordx2 s[36:37], s[0:1], s3 offset:0
  s_load_dwordx2 s[28:29], s[0:1], 96
  v_lshrrev_b32 v1, 6, v0
  v_and_b32 v0, 63, v0
  v_readfirstlane_b32 s9, v1
  s_lshr_b32 s8, s2, 3
  v_lshrrev_b32 v40, 4, v0
  s_sub_u32 s49, s9, 1
  s_cmp_ge_u32 s49, 6
  s_cbranch_scc1 L_rest
  s_and_b32 s10, s8, 3
  s_mul_i32 s10, s10, 6
  s_add_u32 s10, s10, s49
  s_mul_i32 s10, s10, 48
  s_and_b32 s11, s2, 3
  s_lshr_b32 s44, s2, 5
  s_lshl3_add_u32 s11, s11, s44
  s_lshl_b32 s11, s11, 8
  s_lshl_b32 s44, s10, 12
  s_add_u32 s44, s44, s11
  v_and_b32 v3, 15, v0
  v_mul_u32_u24 v40, 3, v40
  v_lshlrev_b32 v3, 4, v3
  v_lshl_add_u32 v62, v40, 2, s10
  v_lshl_or_b32 v3, v40, 14, v3
  s_mov_b32 s22, 0x480000
  s_mov_b32 s23, 0x20000
  s_setprio 3
  s_waitcnt lgkmcnt(0)
  global_load_dwordx3 v[248:250], v62, s[36:37]
  buffer_load_dwordx4 v[224:227], v3, s[20:23], s44 offen nt
  s_addk_i32 s44, 0x2000
  buffer_load_dwordx4 v[228:231], v3, s[20:23], s44 offen nt
  s_addk_i32 s44, 0x2000
  buffer_load_dwordx4 v[232:235], v3, s[20:23], s44 offen nt
  s_addk_i32 s44, 0x2000
  buffer_load_dwordx4 v[236:239], v3, s[20:23], s44 offen nt
  s_addk_i32 s44, 0x2000
  buffer_load_dwordx4 v[240:243], v3, s[20:23], s44 offen nt
  s_addk_i32 s44, 0x2000
  buffer_load_dwordx4 v[244:247], v3, s[20:23], s44 offen nt
L_rest:
  s_load_dwordx2 s[12:13], s[0:1], s3 offset:8
  s_load_dwordx2 s[16:17], s[0:1], s3 offset:16
  s_load_dwordx2 s[24:25], s[0:1], s3 offset:32
  s_load_dwordx2 s[32:33], s[0:1], 80
  s_and_b32 s10, s2, 7
  s_lshl_b32 s10, s10, 5
  s_or_b32 s8, s8, s10
  s_and_b32 s7, s8, 0x7f
  s_mov_b32 s30, 0x400000
  s_mov_b32 s31, 0x20000
  v_lshlrev_b32 v1, 4, v0
  v_and_b32 v55, 3, v0
  v_lshrrev_b32 v59, 2, v0
  s_cmp_lg_u32 s9, 0
  s_cbranch_scc1 L_t0
L_clear:
  s_setprio 3
  v_mov_b32 v40, -1
  v_mov_b32 v41, -1
  v_mov_b32 v42, -1
  v_mov_b32 v43, -1
  v_mov_b32 v44, 0
  v_mov_b32 v45, 0
  ds_write_b64 v44, v[44:45] offset:1408
  s_mov_b64 exec, 0xff
  ds_write_b128 v1, v[40:43] offset:1280
  s_mov_b64 exec, -1
  s_and_b32 s58, s8, 0x80
  s_add_u32 s58, s58, 65536
  s_lshl_b32 s48, s8, 11
  s_add_u32 s48, s48, 262144
  s_mul_i32 s4, s8, 2304
  s_add_u32 s4, s4, 1048576
  s_waitcnt lgkmcnt(0)
  s_load_dword s38, s[28:29], s58
  s_getreg_b32 s62, hwreg(HW_REG_XCC_ID, 0, 4)
  v_mov_b32 v44, -1
  v_mov_b32 v45, -1
  v_mov_b32 v46, -1
  v_mov_b32 v47, s62
L_t0:
  s_barrier
  s_and_b32 s6, s8, 7
  s_lshr_b32 s5, s7, 3
  s_mov_b32 s14, 0x2000000
  s_mov_b32 s15, 0x20000
  s_mov_b32 s18, 0x2000000
  s_mov_b32 s19, 0x20000
  s_mov_b32 s41, 0x8000
  v_and_b32 v59, 3, v59
  v_and_b32 v2, 48, v0
  v_lshl_or_b32 v2, v55, 10, v2
  v_lshl_or_b32 v2, v59, 8, v2
  s_mov_b32 s10, s9
  s_lshl_b32 s42, s7, 6
  s_add_u32 s42, s42, s10
  s_lshl_b32 s42, s42, 12
  s_mov_b32 s43, s42
  v_and_b32 v55, 1, v0
  v_lshlrev_b32 v55, 4, v55
  v_mov_b32 v59, 0xffff
  v_lshlrev_b32 v55, v55, v59
  v_bfe_u32 v59, v0, 1, 2
  v_lshlrev_b32_e64 v59, v59, 1
  v_bfe_i32 v4, v59, 0, 1
  v_bfe_i32 v5, v59, 1, 1
  v_bfe_i32 v6, v59, 2, 1
  v_bfe_i32 v7, v59, 3, 1
  v_and_b32 v4, v4, v55
  v_and_b32 v5, v5, v55
  v_and_b32 v6, v6, v55
  v_and_b32 v7, v7, v55
  s_mov_b32 s40, 0x3e0293ee
  s_mov_b32 s47, 65536
  s_mov_b32 s26, 0x480000
  s_mov_b32 s27, 0x20000
  v_mov_b32 v54, 0
  s_cmp_ge_u32 s49, 6
  s_cbranch_scc1 L_noq
  v_and_b32 v55, 15, v0
  v_lshrrev_b32 v59, 4, v0
  v_lshlrev_b32 v59, 3, v59
  v_lshl_or_b32 v55, v55, 5, v59
  s_lshl_b32 s10, s49, 9
  v_add_u32 v3, s10, v55
  s_cmp_eq_u32 s49, 0
  s_cbranch_scc1 P_c3
  s_cmp_eq_u32 s49, 1
  s_cbranch_scc1 P_B67
  s_cmp_eq_u32 s49, 2
  s_cbranch_scc1 P_w6
L_hopret:
  s_waitcnt lgkmcnt(0)
  s_waitcnt vmcnt(6)
  v_and_b32 v24, 0xffff, v248
  v_lshlrev_b32 v25, 16, v248
  v_lshrrev_b32 v26, 16, v248
  v_and_b32 v27, 0xffff0000, v248
  v_and_b32 v28, 0xffff, v249
  v_lshlrev_b32 v29, 16, v249
  v_lshrrev_b32 v30, 16, v249
  v_and_b32 v31, 0xffff0000, v249
  v_and_b32 v32, 0xffff, v250
  v_lshlrev_b32 v33, 16, v250
  v_lshrrev_b32 v34, 16, v250
  v_and_b32 v35, 0xffff0000, v250
  s_waitcnt vmcnt(5)
  v_dot2_f32_bf16 v40, v224, v24, 0
  v_dot2_f32_bf16 v41, v224, v25, 0
  v_dot2_f32_bf16 v42, v225, v24, 0
  v_dot2_f32_bf16 v43, v225, v25, 0
  v_dot2_f32_bf16 v44, v226, v24, 0
  v_dot2_f32_bf16 v45, v226, v25, 0
  v_dot2_f32_bf16 v46, v227, v24, 0
  v_dot2_f32_bf16 v47, v227, v25, 0
  s_waitcnt vmcnt(4)
  v_dot2_f32_bf16 v40, v228, v26, v40
  v_dot2_f32_bf16 v41, v228, v27, v41
  v_dot2_f32_bf16 v42, v229, v26, v42
  v_dot2_f32_bf16 v43, v229, v27, v43
  v_dot2_f32_bf16 v44, v230, v26, v44
  v_dot2_f32_bf16 v45, v230, v27, v45
  v_dot2_f32_bf16 v46, v231, v26, v46
  v_dot2_f32_bf16 v47, v231, v27, v47
  s_waitcnt vmcnt(3)
  v_dot2_f32_bf16 v40, v232, v28, v40
  v_dot2_f32_bf16 v41, v232, v29, v41
  v_dot2_f32_bf16 v42, v233, v28, v42
  v_dot2_f32_bf16 v43, v233, v29, v43
  v_dot2_f32_bf16 v44, v234, v28, v44
  v_dot2_f32_bf16 v45, v234, v29, v45
  v_dot2_f32_bf16 v46, v235, v28, v46
  v_dot2_f32_bf16 v47, v235, v29, v47
  s_waitcnt vmcnt(2)
  v_dot2_f32_bf16 v40, v236, v30, v40
  v_dot2_f32_bf16 v41, v236, v31, v41
  v_dot2_f32_bf16 v42, v237, v30, v42
  v_dot2_f32_bf16 v43, v237, v31, v43
  v_dot2_f32_bf16 v44, v238, v30, v44
  v_dot2_f32_bf16 v45, v238, v31, v45
  v_dot2_f32_bf16 v46, v239, v30, v46
  v_dot2_f32_bf16 v47, v239, v31, v47
  s_waitcnt vmcnt(1)
  v_dot2_f32_bf16 v40, v240, v32, v40
  v_dot2_f32_bf16 v41, v240, v33, v41
  v_dot2_f32_bf16 v42, v241, v32, v42
  v_dot2_f32_bf16 v43, v241, v33, v43
  v_dot2_f32_bf16 v44, v242, v32, v44
  v_dot2_f32_bf16 v45, v242, v33, v45
  v_dot2_f32_bf16 v46, v243, v32, v46
  v_dot2_f32_bf16 v47, v243, v33, v47
  s_waitcnt vmcnt(0)
  v_dot2_f32_bf16 v40, v244, v34, v40
  v_dot2_f32_bf16 v41, v244, v35, v41
  v_dot2_f32_bf16 v42, v245, v34, v42
  v_dot2_f32_bf16 v43, v245, v35, v43
  v_dot2_f32_bf16 v44, v246, v34, v44
  v_dot2_f32_bf16 v45, v246, v35, v45
  v_dot2_f32_bf16 v46, v247, v34, v46
  v_dot2_f32_bf16 v47, v247, v35, v47
  v_permlane32_swap_b32 v40, v44
  v_permlane32_swap_b32 v41, v45
  v_permlane32_swap_b32 v42, v46
  v_permlane32_swap_b32 v43, v47
  v_add_f32 v40, v40, v44
  v_add_f32 v41, v41, v45
  v_add_f32 v42, v42, v46
  v_add_f32 v43, v43, v47
  s_nop 0
  v_permlane16_swap_b32 v40, v42
  v_permlane16_swap_b32 v41, v43
  v_add_f32 v40, v40, v42
  v_add_f32 v41, v41, v43
  ds_write_b64 v3, v[40:41] offset:2048
  v_mov_b32 v55, 1
  s_mov_b64 exec, 1
  ds_add_u32 v54, v55 offset:1408
  s_mov_b64 exec, -1
  buffer_load_dwordx4 v[64:67], v2, s[12:15], s42 offen offset:0 nt
  buffer_load_dwordx4 v[68:71], v2, s[12:15], s42 offen offset:64 nt
  buffer_load_dwordx4 v[72:75], v2, s[12:15], s42 offen offset:128 nt
  buffer_load_dwordx4 v[76:79], v2, s[12:15], s42 offen offset:192 nt
  s_add_u32 s42, s42, s41
  s_branch L_pre1
L_noq:
  s_cmp_eq_u32 s9, 0
  s_cbranch_scc1 L_ctl
  s_setprio 3
  s_waitcnt lgkmcnt(0)
  s_branch L_dry_ret
L_ctl:
  s_lshl_b32 s11, s8, 7
  s_add_u32 s11, s11, 196608
  buffer_store_dwordx4 v[40:43], v1, s[28:31], s48 offen sc1
  buffer_store_dwordx4 v[40:43], v1, s[28:31], s4 offen sc1
  buffer_store_dwordx4 v[40:43], v1, s[28:31], s4 offen offset:1024 sc1
  s_mov_b64 exec, 0xffff
  buffer_store_dwordx4 v[40:43], v1, s[28:31], s4 offen offset:2048 sc1
  s_mov_b64 exec, 0xff
  buffer_store_dwordx4 v[44:47], v1, s[28:31], s11 offen sc1
  s_mov_b64 exec, -1
  v_lshlrev_b32 v3, 3, v0
  s_xor_b32 s4, s8, 0
  s_lshl_b32 s4, s4, 7
  s_and_b32 s48, s4, 0x7c00
  s_lshr_b32 s59, s48, 3
  s_add_u32 s59, s59, 131072
  s_mov_b32 s45, s48
  s_mov_b32 s46, 0
  s_lshl_b32 s4, s4, 3
  s_lshl_b32 s48, s48, 3
  s_add_u32 s4, s4, 1703936
  s_add_u32 s48, s48, 1703936
  s_add_u32 s69, s48, 4096
  buffer_load_dwordx4 v[64:67], v2, s[12:15], s42 offen offset:0 nt
  buffer_load_dwordx4 v[68:71], v2, s[12:15], s42 offen offset:64 nt
  buffer_load_dwordx4 v[72:75], v2, s[12:15], s42 offen offset:128 nt
  buffer_load_dwordx4 v[76:79], v2, s[12:15], s42 offen offset:192 nt
  s_add_u32 s42, s42, s41
  s_lshl_b32 s10, s8, 7
  v_mov_b32 v62, s62
  s_waitcnt lgkmcnt(0)
  s_add_u32 s38, s38, 2654435769
  v_mov_b32 v63, s38
  s_mov_b64 exec, 1
  buffer_store_dwordx2 v[62:63], v54, s[28:31], s10 offen sc1
  s_mov_b64 exec, -1
L_cnt:
  ds_read_b32 v55, v54 offset:1408
  s_waitcnt lgkmcnt(0)
  v_cmp_ne_u32 vcc, 6, v55
  s_cbranch_vccz L_cnt_ok
  s_addk_i32 s47, -1
  s_cmpk_gt_i32 s47, 0
  s_cbranch_scc1 L_cnt
L_cnt_ok:
  ds_read_b64 v[24:25], v3 offset:2048
  ds_read_b64 v[26:27], v3 offset:2560
  ds_read_b64 v[28:29], v3 offset:3072
  ds_read_b64 v[30:31], v3 offset:3584
  ds_read_b64 v[32:33], v3 offset:4096
  ds_read_b64 v[34:35], v3 offset:4608
  s_waitcnt lgkmcnt(0)
  v_pk_add_f32 v[24:25], v[24:25], v[26:27]
  v_pk_add_f32 v[28:29], v[28:29], v[30:31]
  v_pk_add_f32 v[32:33], v[32:33], v[34:35]
  v_pk_add_f32 v[24:25], v[24:25], v[28:29]
  v_pk_add_f32 v[24:25], v[24:25], v[32:33]
  v_mov_b32 v27, s38
  v_mov_b32 v26, v25
  v_mov_b32 v25, s38
  s_mov_b32 s39, s38
  v_lshlrev_b32 v3, 7, v0
  s_waitcnt vmcnt(5)
  buffer_store_dwordx4 v[24:27], v1, s[28:31], s4 offen
  buffer_load_dwordx4 v[80:83], v2, s[12:15], s42 offen offset:0 nt
  buffer_load_dwordx4 v[84:87], v2, s[12:15], s42 offen offset:64 nt
  buffer_load_dwordx4 v[88:91], v2, s[12:15], s42 offen offset:128 nt
  buffer_load_dwordx4 v[92:95], v2, s[12:15], s42 offen offset:192 nt
  s_add_u32 s42, s42, s41
  s_waitcnt vmcnt(8)
  buffer_load_dwordx4 v[96:99], v1, s[16:19], s43 offen offset:0 nt
  s_waitcnt vmcnt(8)
  buffer_load_dwordx4 v[100:103], v1, s[16:19], s43 offen offset:1024 nt
  s_waitcnt vmcnt(8)
  buffer_load_dwordx4 v[104:107], v1, s[16:19], s43 offen offset:2048 nt
  s_waitcnt vmcnt(8)
  buffer_load_dwordx4 v[108:111], v1, s[16:19], s43 offen offset:3072 nt
  s_add_u32 s43, s43, s41
  s_waitcnt vmcnt(8)
  buffer_load_dwordx4 v[112:115], v2, s[12:15], s42 offen offset:0 nt
  s_waitcnt vmcnt(8)
  buffer_load_dwordx4 v[116:119], v2, s[12:15], s42 offen offset:64 nt
  s_waitcnt vmcnt(8)
  buffer_load_dwordx4 v[120:123], v2, s[12:15], s42 offen offset:128 nt
  s_waitcnt vmcnt(8)
  buffer_load_dwordx4 v[124:127], v2, s[12:15], s42 offen offset:192 nt
  s_add_u32 s42, s42, s41
  s_waitcnt vmcnt(8)
  buffer_load_dwordx4 v[128:131], v1, s[16:19], s43 offen offset:0 nt
  s_waitcnt vmcnt(8)
  buffer_load_dwordx4 v[132:135], v1, s[16:19], s43 offen offset:1024 nt
  s_waitcnt vmcnt(8)
  buffer_load_dwordx4 v[136:139], v1, s[16:19], s43 offen offset:2048 nt
  s_waitcnt vmcnt(8)
  buffer_load_dwordx4 v[140:143], v1, s[16:19], s43 offen offset:3072 nt
  s_add_u32 s43, s43, s41
  s_waitcnt vmcnt(8)
  buffer_load_dwordx4 v[144:147], v2, s[12:15], s42 offen offset:0 nt
  s_waitcnt vmcnt(8)
  buffer_load_dwordx4 v[148:151], v2, s[12:15], s42 offen offset:64 nt
  s_waitcnt vmcnt(8)
  buffer_load_dwordx4 v[152:155], v2, s[12:15], s42 offen offset:128 nt
  s_waitcnt vmcnt(8)
  buffer_load_dwordx4 v[156:159], v2, s[12:15], s42 offen offset:192 nt
  s_add_u32 s42, s42, s41
  s_waitcnt vmcnt(8)
  buffer_load_dwordx4 v[160:163], v1, s[16:19], s43 offen offset:0 nt
  s_waitcnt vmcnt(8)
  buffer_load_dwordx4 v[164:167], v1, s[16:19], s43 offen offset:1024 nt
  s_waitcnt vmcnt(8)
  buffer_load_dwordx4 v[168:171], v1, s[16:19], s43 offen offset:2048 nt
  s_waitcnt vmcnt(8)
  buffer_load_dwordx4 v[172:175], v1, s[16:19], s43 offen offset:3072 nt
  s_add_u32 s43, s43, s41
  s_mov_b64 exec, 0xff
  buffer_load_dwordx2 v[252:253], v3, s[28:31], s45 offen sc1
  s_mov_b64 exec, -1
  buffer_load_dwordx4 v[192:195], v1, s[28:31], s48 offen offset:0 nt
  buffer_load_dwordx4 v[196:199], v1, s[28:31], s48 offen offset:1024 nt
  buffer_load_dwordx4 v[200:203], v1, s[28:31], s48 offen offset:2048 nt
  buffer_load_dwordx4 v[204:207], v1, s[28:31], s48 offen offset:3072 nt
  buffer_load_dwordx4 v[208:211], v1, s[28:31], s69 offen offset:0 nt
  buffer_load_dwordx4 v[212:215], v1, s[28:31], s69 offen offset:1024 nt
  buffer_load_dwordx4 v[216:219], v1, s[28:31], s69 offen offset:2048 nt
  buffer_load_dwordx4 v[220:223], v1, s[28:31], s69 offen offset:3072 nt
  s_branch L_gather2
L_gather1:
  s_mov_b64 exec, 0xff
  buffer_load_dwordx2 v[252:253], v3, s[28:31], s45 offen sc1
  s_mov_b64 exec, -1
  buffer_load_dwordx4 v[192:195], v1, s[28:31], s48 offen offset:0 sc1
  buffer_load_dwordx4 v[196:199], v1, s[28:31], s48 offen offset:1024 sc1
  buffer_load_dwordx4 v[200:203], v1, s[28:31], s48 offen offset:2048 sc1
  buffer_load_dwordx4 v[204:207], v1, s[28:31], s48 offen offset:3072 sc1
  buffer_load_dwordx4 v[208:211], v1, s[28:31], s69 offen offset:0 sc1
  buffer_load_dwordx4 v[212:215], v1, s[28:31], s69 offen offset:1024 sc1
  buffer_load_dwordx4 v[216:219], v1, s[28:31], s69 offen offset:2048 sc1
  buffer_load_dwordx4 v[220:223], v1, s[28:31], s69 offen offset:3072 sc1
L_gather2:
  s_waitcnt vmcnt(8)
  s_mov_b64 exec, 0xff
  v_cmp_ne_u32 vcc, s38, v253
  v_cmp_ne_u32 s[50:51], s62, v252
  s_mov_b64 exec, -1
  s_cbranch_vccnz L_again
  s_cmp_eq_u64 s[50:51], 0
  s_cbranch_scc1 L_chk
  s_cmp_lg_u32 s46, 0
  s_cbranch_scc1 L_chk
  buffer_store_dwordx4 v[24:27], v1, s[28:31], s4 offen sc1
  s_mov_b32 s46, 1
L_chk:
  s_waitcnt vmcnt(0)
  v_max_u32 v55, v193, v195
  v_min_u32 v59, v193, v195
  v_max3_u32 v55, v55, v197, v199
  v_min3_u32 v59, v59, v197, v199
  v_max3_u32 v55, v55, v201, v203
  v_min3_u32 v59, v59, v201, v203
  v_max3_u32 v55, v55, v205, v207
  v_min3_u32 v59, v59, v205, v207
  v_max3_u32 v55, v55, v209, v211
  v_min3_u32 v59, v59, v209, v211
  v_max3_u32 v55, v55, v213, v215
  v_min3_u32 v59, v59, v213, v215
  v_max3_u32 v55, v55, v217, v219
  v_min3_u32 v59, v59, v217, v219
  v_max3_u32 v55, v55, v221, v223
  v_min3_u32 v59, v59, v221, v223
  v_cmp_ne_u32 vcc, s38, v55
  v_cmp_ne_u32 s[50:51], s38, v59
  s_mov_b64 exec, -1
  s_or_b64 vcc, vcc, s[50:51]
  s_cbranch_vccz L_gotq
L_again:
  s_waitcnt vmcnt(0)
  s_addk_i32 s47, -1
  s_cmpk_gt_i32 s47, 0
  s_cbranch_scc1 L_gather1
L_gotq:
  v_add_f32 v192, v192, v196
  v_add_f32 v200, v200, v204
  v_add_f32 v194, v194, v198
  v_add_f32 v202, v202, v206
  v_add_f32 v208, v208, v212
  v_add_f32 v216, v216, v220
  v_add_f32 v210, v210, v214
  v_add_f32 v218, v218, v222
  v_add_f32 v192, v192, v200
  v_add_f32 v194, v194, v202
  v_add_f32 v208, v208, v216
  v_add_f32 v210, v210, v218
  v_lshlrev_b32 v26, 2, v0
  v_cvt_pk_bf16_f32 v248, v192, v194
  v_cvt_pk_bf16_f32 v250, v208, v210
  v_mov_b32 v55, 1
  v_mov_b32 v59, s38
  ds_write2_b32 v26, v248, v250 offset0:0 offset1:64
  s_and_b32 s10, s8, 0x7f
  s_and_b32 s11, s8, 7
  s_waitcnt lgkmcnt(0)
  ds_write_b32 v54, v55 offset:1412
  s_cbranch_scc1 L_noep
  s_and_b32 s11, s8, 0x80
  s_lshl_b32 s11, s11, 4
  s_lshr_b32 s10, s10, 1
  s_add_u32 s10, s10, s11
  s_add_u32 s10, s10, 131072
  v_lshlrev_b32 v62, 7, v0
  s_mov_b64 exec, 0x1ff
  buffer_store_dword v59, v62, s[28:31], s10 offen sc1
  s_mov_b64 exec, -1
L_noep:
  s_branch L_readq
L_dry_ret:
  s_mov_b64 exec, -1
  buffer_load_dwordx4 v[64:67], v2, s[12:15], s42 offen offset:0 nt
  buffer_load_dwordx4 v[68:71], v2, s[12:15], s42 offen offset:64 nt
  buffer_load_dwordx4 v[72:75], v2, s[12:15], s42 offen offset:128 nt
  buffer_load_dwordx4 v[76:79], v2, s[12:15], s42 offen offset:192 nt
  s_add_u32 s42, s42, s41
L_pre1:
  buffer_load_dwordx4 v[80:83], v2, s[12:15], s42 offen offset:0 nt
  buffer_load_dwordx4 v[84:87], v2, s[12:15], s42 offen offset:64 nt
  buffer_load_dwordx4 v[88:91], v2, s[12:15], s42 offen offset:128 nt
  buffer_load_dwordx4 v[92:95], v2, s[12:15], s42 offen offset:192 nt
  s_add_u32 s42, s42, s41
L_pre2:
  buffer_load_dwordx4 v[96:99], v1, s[16:19], s43 offen offset:0 nt
  buffer_load_dwordx4 v[100:103], v1, s[16:19], s43 offen offset:1024 nt
  buffer_load_dwordx4 v[104:107], v1, s[16:19], s43 offen offset:2048 nt
  buffer_load_dwordx4 v[108:111], v1, s[16:19], s43 offen offset:3072 nt
  s_add_u32 s43, s43, s41
L_pre3:
  buffer_load_dwordx4 v[112:115], v2, s[12:15], s42 offen offset:0 nt
  buffer_load_dwordx4 v[116:119], v2, s[12:15], s42 offen offset:64 nt
  s_waitcnt vmcnt(13)
  buffer_load_dwordx4 v[120:123], v2, s[12:15], s42 offen offset:128 nt
  s_waitcnt vmcnt(13)
  buffer_load_dwordx4 v[124:127], v2, s[12:15], s42 offen offset:192 nt
  s_add_u32 s42, s42, s41
L_pre4:
  s_waitcnt vmcnt(13)
  buffer_load_dwordx4 v[128:131], v1, s[16:19], s43 offen offset:0 nt
  s_waitcnt vmcnt(13)
  buffer_load_dwordx4 v[132:135], v1, s[16:19], s43 offen offset:1024 nt
  s_waitcnt vmcnt(13)
  buffer_load_dwordx4 v[136:139], v1, s[16:19], s43 offen offset:2048 nt
  s_waitcnt vmcnt(13)
  buffer_load_dwordx4 v[140:143], v1, s[16:19], s43 offen offset:3072 nt
  s_add_u32 s43, s43, s41
L_pre5:
  s_waitcnt vmcnt(13)
  buffer_load_dwordx4 v[144:147], v2, s[12:15], s42 offen offset:0 nt
  s_waitcnt vmcnt(13)
  buffer_load_dwordx4 v[148:151], v2, s[12:15], s42 offen offset:64 nt
  s_waitcnt vmcnt(13)
  buffer_load_dwordx4 v[152:155], v2, s[12:15], s42 offen offset:128 nt
  s_waitcnt vmcnt(13)
  buffer_load_dwordx4 v[156:159], v2, s[12:15], s42 offen offset:192 nt
  s_add_u32 s42, s42, s41
L_pre6:
  s_waitcnt vmcnt(13)
  buffer_load_dwordx4 v[160:163], v1, s[16:19], s43 offen offset:0 nt
  s_waitcnt vmcnt(13)
  buffer_load_dwordx4 v[164:167], v1, s[16:19], s43 offen offset:1024 nt
  s_waitcnt vmcnt(13)
  buffer_load_dwordx4 v[168:171], v1, s[16:19], s43 offen offset:2048 nt
  s_waitcnt vmcnt(13)
  buffer_load_dwordx4 v[172:175], v1, s[16:19], s43 offen offset:3072 nt
  s_add_u32 s43, s43, s41
L_qspin:
  ds_read_b32 v55, v54 offset:1412
  s_waitcnt lgkmcnt(0)
  v_cmp_eq_u32 vcc, 0, v55
  s_cbranch_vccz L_readq
  s_addk_i32 s47, -1
  s_cmpk_gt_i32 s47, 0
  s_cbranch_scc1 L_qspin
L_readq:
  v_bfe_u32 v55, v0, 3, 1
  v_and_b32 v59, 48, v0
  v_lshl_or_b32 v55, v55, 8, v59
  ds_read_b128 v[8:11], v55 offset:0
  ds_read_b128 v[12:15], v55 offset:64
  ds_read_b128 v[16:19], v55 offset:128
  ds_read_b128 v[20:23], v55 offset:192
  s_lshl_b32 s10, s9, 10
  v_add_u32 v224, s10, v1
  s_lshl_b32 s10, s9, 3
  v_lshrrev_b32 v225, 2, v55
  v_and_b32 v225, 64, v225
  v_add_u32 v225, s10, v225
  v_lshlrev_b32 v249, 2, v0
  s_add_u32 s49, s9, 5
  s_and_b32 s49, s49, 7
  s_movk_i32 s11, 0x2400
  v_lshrrev_b32 v59, 4, v0
  v_and_b32 v226, 0xff, v1
  v_mad_u32_u24 v226, v59, s11, v226
  s_lshl_b32 s10, s49, 4
  v_and_b32 v59, 15, v0
  v_add_u32 v59, s10, v59
  v_cmp_gt_u32 vcc, 72, v59
  v_mov_b32 v59, 0x40000000
  s_mul_i32 s45, s7, 0x9000
  s_lshl_b32 s10, s49, 8
  s_add_u32 s45, s45, s10
  v_cndmask_b32 v226, v59, v226, vcc
  s_add_u32 s46, s45, 4608
  v_lshrrev_b32 v55, 4, v0
  v_lshlrev_b32 v228, 7, v55
  v_bfe_u32 v59, v0, 2, 2
  v_lshlrev_b32 v229, 7, v59
  v_lshl_or_b32 v229, v55, 6, v229
  v_lshl_or_b32 v227, v59, 4, v228
  v_and_b32 v59, 3, v0
  v_lshl_or_b32 v229, v59, 4, v229
  v_and_b32 v59, 1, v0
  v_lshl_or_b32 v227, v59, 3, v227
  v_and_b32 v59, 2, v0
  v_lshl_or_b32 v227, v59, 5, v227
  v_mov_b32 v230, 0
  s_lshl_b32 s48, s8, 11
  s_add_u32 s48, s48, 262144
  s_mul_i32 s4, s8, 2304
  s_lshl_b32 s10, s49, 9
  s_add_u32 s4, s4, s10
  s_add_u32 s4, s4, 1048576
  s_and_b32 s69, s8, 0xf8
  s_lshl_b32 s69, s69, 7
  s_and_b32 s10, s8, 4
  s_lshl_b32 s10, s10, 4
  s_add_u32 s69, s69, s10
  s_add_u32 s69, s69, 196608
  s_cmp_eq_u32 s49, 4
  s_cselect_b32 s50, 0x00ff00ff, -1
  s_mov_b32 s51, 0
  s_mov_b32 vcc_lo, 0x00ff00ff
  s_mov_b32 vcc_hi, 0xff00ff00
  s_waitcnt lgkmcnt(0)
  v_mfma_f32_16x16x32_bf16 v[24:27], v[64:67], v[8:11], 0
  v_mfma_f32_16x16x32_bf16 v[24:27], v[68:71], v[12:15], v[24:27]
  v_mfma_f32_16x16x32_bf16 v[24:27], v[72:75], v[16:19], v[24:27]
  v_mfma_f32_16x16x32_bf16 v[24:27], v[76:79], v[20:23], v[24:27]
  v_mfma_f32_16x16x32_bf16 v[28:31], v[80:83], v[8:11], 0
  v_mfma_f32_16x16x32_bf16 v[28:31], v[84:87], v[12:15], v[28:31]
  v_mfma_f32_16x16x32_bf16 v[28:31], v[88:91], v[16:19], v[28:31]
  v_mfma_f32_16x16x32_bf16 v[28:31], v[92:95], v[20:23], v[28:31]
  s_nop 3
  v_max3_f32 v55, v24, v25, v26
  s_nop 2
  v_max3_f32 v55, v55, v27, v28
  v_max3_f32 v55, v55, v29, v30
  v_max_f32 v52, v55, v31
  v_mov_b32 v55, v52
  s_nop 1
  v_permlane16_swap_b32 v52, v55
  v_max_f32 v52, v52, v55
  v_mov_b32 v55, v52
  s_nop 1
  v_permlane32_swap_b32 v52, v55
  v_max_f32 v52, v52, v55
  v_mul_f32 v58, 0xbe0293ee, v52
  v_fma_f32 v24, v24, s40, v58
  v_fma_f32 v25, v25, s40, v58
  v_fma_f32 v26, v26, s40, v58
  v_fma_f32 v27, v27, s40, v58
  v_fma_f32 v28, v28, s40, v58
  v_fma_f32 v29, v29, s40, v58
  v_fma_f32 v30, v30, s40, v58
  v_fma_f32 v31, v31, s40, v58
  v_exp_f32 v24, v24
  v_exp_f32 v25, v25
  v_exp_f32 v26, v26
  v_exp_f32 v27, v27
  v_exp_f32 v28, v28
  v_exp_f32 v29, v29
  v_exp_f32 v30, v30
  v_exp_f32 v31, v31
  v_pk_add_f32 v[40:41], v[24:25], v[26:27]
  v_pk_add_f32 v[62:63], v[28:29], v[30:31]
  v_pk_add_f32 v[56:57], v[40:41], v[62:63]
  v_cvt_pk_bf16_f32 v24, v24, v24
  v_cvt_pk_bf16_f32 v25, v25, v25
  v_cvt_pk_bf16_f32 v26, v26, v26
  v_cvt_pk_bf16_f32 v27, v27, v27
  v_cvt_pk_bf16_f32 v28, v28, v28
  v_cvt_pk_bf16_f32 v29, v29, v29
  v_cvt_pk_bf16_f32 v30, v30, v30
  v_cvt_pk_bf16_f32 v31, v31, v31
  v_and_b32 v40, v24, v4
  v_and_b32 v41, v24, v5
  v_and_b32 v42, v24, v6
  v_and_b32 v43, v24, v7
  v_and_b32 v44, v25, v4
  v_and_b32 v45, v25, v5
  v_and_b32 v46, v25, v6
  v_and_b32 v47, v25, v7
  v_mfma_f32_16x16x32_bf16 v[48:51], v[40:43], v[96:99], 0
  v_and_b32 v40, v26, v4
  v_and_b32 v41, v26, v5
  v_and_b32 v42, v26, v6
  v_and_b32 v43, v26, v7
  v_mfma_f32_16x16x32_bf16 v[48:51], v[44:47], v[100:103], v[48:51]
  v_and_b32 v44, v27, v4
  v_and_b32 v45, v27, v5
  v_and_b32 v46, v27, v6
  v_and_b32 v47, v27, v7
  v_mfma_f32_16x16x32_bf16 v[48:51], v[40:43], v[104:107], v[48:51]
  s_nop 0
  v_mfma_f32_16x16x32_bf16 v[48:51], v[44:47], v[108:111], v[48:51]
  s_waitcnt vmcnt(11)
  buffer_load_dwordx4 v[176:179], v2, s[12:15], s42 offen offset:0 nt
  s_waitcnt vmcnt(11)
  buffer_load_dwordx4 v[180:183], v2, s[12:15], s42 offen offset:64 nt
  s_waitcnt vmcnt(11)
  buffer_load_dwordx4 v[184:187], v2, s[12:15], s42 offen offset:128 nt
  s_waitcnt vmcnt(11)
  buffer_load_dwordx4 v[188:191], v2, s[12:15], s42 offen offset:192 nt
  s_add_u32 s42, s42, s41
  v_mfma_f32_16x16x32_bf16 v[32:35], v[112:115], v[8:11], 0
  v_mfma_f32_16x16x32_bf16 v[32:35], v[116:119], v[12:15], v[32:35]
  v_mfma_f32_16x16x32_bf16 v[32:35], v[120:123], v[16:19], v[32:35]
  v_mfma_f32_16x16x32_bf16 v[32:35], v[124:127], v[20:23], v[32:35]
  s_waitcnt vmcnt(11)
  buffer_load_dwordx4 v[64:67], v1, s[16:19], s43 offen offset:0 nt
  s_waitcnt vmcnt(11)
  buffer_load_dwordx4 v[68:71], v1, s[16:19], s43 offen offset:1024 nt
  s_waitcnt vmcnt(11)
  buffer_load_dwordx4 v[72:75], v1, s[16:19], s43 offen offset:2048 nt
  s_waitcnt vmcnt(11)
  buffer_load_dwordx4 v[76:79], v1, s[16:19], s43 offen offset:3072 nt
  s_add_u32 s43, s43, s41
  v_and_b32 v40, v28, v4
  v_and_b32 v41, v28, v5
  v_and_b32 v42, v28, v6
  v_and_b32 v43, v28, v7
  v_and_b32 v44, v29, v4
  v_and_b32 v45, v29, v5
  v_and_b32 v46, v29, v6
  v_and_b32 v47, v29, v7
  v_mfma_f32_16x16x32_bf16 v[48:51], v[40:43], v[128:131], v[48:51]
  v_and_b32 v40, v30, v4
  v_and_b32 v41, v30, v5
  v_and_b32 v42, v30, v6
  v_and_b32 v43, v30, v7
  v_mfma_f32_16x16x32_bf16 v[48:51], v[44:47], v[132:135], v[48:51]
  v_and_b32 v44, v31, v4
  v_and_b32 v45, v31, v5
  v_and_b32 v46, v31, v6
  v_and_b32 v47, v31, v7
  v_mfma_f32_16x16x32_bf16 v[48:51], v[40:43], v[136:139], v[48:51]
  s_nop 0
  v_mfma_f32_16x16x32_bf16 v[48:51], v[44:47], v[140:143], v[48:51]
  s_waitcnt vmcnt(11)
  buffer_load_dwordx4 v[80:83], v2, s[12:15], s42 offen offset:0 nt
  s_waitcnt vmcnt(11)
  buffer_load_dwordx4 v[84:87], v2, s[12:15], s42 offen offset:64 nt
  s_waitcnt vmcnt(11)
  buffer_load_dwordx4 v[88:91], v2, s[12:15], s42 offen offset:128 nt
  s_waitcnt vmcnt(11)
  buffer_load_dwordx4 v[92:95], v2, s[12:15], s42 offen offset:192 nt
  s_add_u32 s42, s42, s41
  v_mfma_f32_16x16x32_bf16 v[36:39], v[144:147], v[8:11], 0
  v_mfma_f32_16x16x32_bf16 v[36:39], v[148:151], v[12:15], v[36:39]
  v_mfma_f32_16x16x32_bf16 v[36:39], v[152:155], v[16:19], v[36:39]
  v_mfma_f32_16x16x32_bf16 v[36:39], v[156:159], v[20:23], v[36:39]
  v_max3_f32 v55, v32, v33, v34
  v_max3_f32 v52, v52, v35, v55
  s_nop 5
  v_max3_f32 v55, v36, v37, v38
  v_max3_f32 v52, v52, v39, v55
  v_mov_b32 v55, v52
  s_nop 1
  v_permlane16_swap_b32 v52, v55
  v_max_f32 v52, v52, v55
  v_mov_b32 v55, v52
  s_nop 1
  v_permlane32_swap_b32 v52, v55
  v_max_f32 v52, v52, v55
  v_mul_f32 v60, 0xbe0293ee, v52
  v_fma_f32 v32, v32, s40, v60
  v_fma_f32 v33, v33, s40, v60
  v_fma_f32 v34, v34, s40, v60
  v_fma_f32 v35, v35, s40, v60
  v_fma_f32 v36, v36, s40, v60
  v_fma_f32 v37, v37, s40, v60
  v_fma_f32 v38, v38, s40, v60
  v_fma_f32 v39, v39, s40, v60
  v_sub_f32 v53, v60, v58
  v_exp_f32 v53, v53
  v_exp_f32 v32, v32
  v_exp_f32 v33, v33
  v_exp_f32 v34, v34
  v_exp_f32 v35, v35
  v_exp_f32 v36, v36
  v_exp_f32 v37, v37
  v_exp_f32 v38, v38
  v_exp_f32 v39, v39
  v_cndmask_b32_dpp v54, v53, v53, vcc row_ror:8 row_mask:0xf bank_mask:0xf
  v_pk_add_f32 v[40:41], v[32:33], v[34:35]
  v_pk_add_f32 v[62:63], v[36:37], v[38:39]
  v_pk_add_f32 v[62:63], v[40:41], v[62:63]
  v_fma_f32 v56, v56, v53, v62
  v_fma_f32 v57, v57, v53, v63
  v_cvt_pk_bf16_f32 v32, v32, v32
  v_cvt_pk_bf16_f32 v33, v33, v33
  v_cvt_pk_bf16_f32 v34, v34, v34
  v_cvt_pk_bf16_f32 v35, v35, v35
  v_cvt_pk_bf16_f32 v36, v36, v36
  v_cvt_pk_bf16_f32 v37, v37, v37
  v_cvt_pk_bf16_f32 v38, v38, v38
  v_cvt_pk_bf16_f32 v39, v39, v39
  s_setprio 2
  s_waitcnt vmcnt(11)
  buffer_load_dwordx4 v[96:99], v1, s[16:19], s43 offen offset:0 nt
  s_waitcnt vmcnt(11)
  buffer_load_dwordx4 v[100:103], v1, s[16:19], s43 offen offset:1024 nt
  s_waitcnt vmcnt(11)
  buffer_load_dwordx4 v[104:107], v1, s[16:19], s43 offen offset:2048 nt
  s_waitcnt vmcnt(11)
  buffer_load_dwordx4 v[108:111], v1, s[16:19], s43 offen offset:3072 nt
  s_add_u32 s43, s43, s41
  v_mul_f32 v48, v54, v48
  v_mul_f32 v49, v54, v49
  v_mul_f32 v50, v54, v50
  v_mul_f32 v51, v54, v51
  v_and_b32 v40, v32, v4
  v_and_b32 v41, v32, v5
  v_and_b32 v42, v32, v6
  v_and_b32 v43, v32, v7
  v_and_b32 v44, v33, v4
  v_and_b32 v45, v33, v5
  v_and_b32 v46, v33, v6
  v_and_b32 v47, v33, v7
  v_mfma_f32_16x16x32_bf16 v[48:51], v[40:43], v[160:163], v[48:51]
  v_and_b32 v40, v34, v4
  v_and_b32 v41, v34, v5
  v_and_b32 v42, v34, v6
  v_and_b32 v43, v34, v7
  v_mfma_f32_16x16x32_bf16 v[48:51], v[44:47], v[164:167], v[48:51]
  v_and_b32 v44, v35, v4
  v_and_b32 v45, v35, v5
  v_and_b32 v46, v35, v6
  v_and_b32 v47, v35, v7
  v_mfma_f32_16x16x32_bf16 v[48:51], v[40:43], v[168:171], v[48:51]
  s_nop 0
  v_mfma_f32_16x16x32_bf16 v[48:51], v[44:47], v[172:175], v[48:51]
  s_waitcnt vmcnt(11)
  buffer_load_dwordx4 v[112:115], v2, s[12:15], s42 offen offset:0 nt
  s_waitcnt vmcnt(11)
  buffer_load_dwordx4 v[116:119], v2, s[12:15], s42 offen offset:64 nt
  s_waitcnt vmcnt(11)
  buffer_load_dwordx4 v[120:123], v2, s[12:15], s42 offen offset:128 nt
  s_waitcnt vmcnt(11)
  buffer_load_dwordx4 v[124:127], v2, s[12:15], s42 offen offset:192 nt
  s_add_u32 s42, s42, s41
  v_mfma_f32_16x16x32_bf16 v[24:27], v[176:179], v[8:11], 0
  v_mfma_f32_16x16x32_bf16 v[24:27], v[180:183], v[12:15], v[24:27]
  v_mfma_f32_16x16x32_bf16 v[24:27], v[184:187], v[16:19], v[24:27]
  v_mfma_f32_16x16x32_bf16 v[24:27], v[188:191], v[20:23], v[24:27]
  s_waitcnt vmcnt(11)
  buffer_load_dwordx4 v[128:131], v1, s[16:19], s43 offen offset:0 nt
  s_waitcnt vmcnt(11)
  buffer_load_dwordx4 v[132:135], v1, s[16:19], s43 offen offset:1024 nt
  s_waitcnt vmcnt(11)
  buffer_load_dwordx4 v[136:139], v1, s[16:19], s43 offen offset:2048 nt
  s_waitcnt vmcnt(11)
  buffer_load_dwordx4 v[140:143], v1, s[16:19], s43 offen offset:3072 nt
  s_add_u32 s43, s43, s41
  v_and_b32 v40, v36, v4
  v_and_b32 v41, v36, v5
  v_and_b32 v42, v36, v6
  v_and_b32 v43, v36, v7
  v_and_b32 v44, v37, v4
  v_and_b32 v45, v37, v5
  v_and_b32 v46, v37, v6
  v_and_b32 v47, v37, v7
  v_mfma_f32_16x16x32_bf16 v[48:51], v[40:43], v[64:67], v[48:51]
  v_and_b32 v40, v38, v4
  v_and_b32 v41, v38, v5
  v_and_b32 v42, v38, v6
  v_and_b32 v43, v38, v7
  v_mfma_f32_16x16x32_bf16 v[48:51], v[44:47], v[68:71], v[48:51]
  v_and_b32 v44, v39, v4
  v_and_b32 v45, v39, v5
  v_and_b32 v46, v39, v6
  v_and_b32 v47, v39, v7
  v_mfma_f32_16x16x32_bf16 v[48:51], v[40:43], v[72:75], v[48:51]
  s_nop 0
  v_mfma_f32_16x16x32_bf16 v[48:51], v[44:47], v[76:79], v[48:51]
  s_cmp_lg_u32 s9, 0
  s_cbranch_scc1 L_pf1
  s_cmp_ge_u32 s7, 72
  s_cbranch_scc1 L_pf1
  s_mov_b64 exec, 0xffff
  buffer_load_dword v248, v249, s[28:31], s59 offen sc1
  s_mov_b64 exec, -1
L_pf1:
  s_waitcnt vmcnt(11)
  buffer_load_dwordx4 v[144:147], v2, s[12:15], s42 offen offset:0 nt
  s_waitcnt vmcnt(11)
  buffer_load_dwordx4 v[148:151], v2, s[12:15], s42 offen offset:64 nt
  s_waitcnt vmcnt(11)
  buffer_load_dwordx4 v[152:155], v2, s[12:15], s42 offen offset:128 nt
  s_waitcnt vmcnt(11)
  buffer_load_dwordx4 v[156:159], v2, s[12:15], s42 offen offset:192 nt
  v_mfma_f32_16x16x32_bf16 v[28:31], v[80:83], v[8:11], 0
  v_mfma_f32_16x16x32_bf16 v[28:31], v[84:87], v[12:15], v[28:31]
  v_mfma_f32_16x16x32_bf16 v[28:31], v[88:91], v[16:19], v[28:31]
  v_mfma_f32_16x16x32_bf16 v[28:31], v[92:95], v[20:23], v[28:31]
  v_max3_f32 v55, v24, v25, v26
  v_max3_f32 v52, v52, v27, v55
  s_nop 5
  v_max3_f32 v55, v28, v29, v30
  v_max3_f32 v52, v52, v31, v55
  v_mov_b32 v55, v52
  s_nop 1
  v_permlane16_swap_b32 v52, v55
  v_max_f32 v52, v52, v55
  v_mov_b32 v55, v52
  s_nop 1
  v_permlane32_swap_b32 v52, v55
  v_max_f32 v52, v52, v55
  v_mul_f32 v58, 0xbe0293ee, v52
  v_fma_f32 v24, v24, s40, v58
  v_fma_f32 v25, v25, s40, v58
  v_fma_f32 v26, v26, s40, v58
  v_fma_f32 v27, v27, s40, v58
  v_fma_f32 v28, v28, s40, v58
  v_fma_f32 v29, v29, s40, v58
  v_fma_f32 v30, v30, s40, v58
  v_fma_f32 v31, v31, s40, v58
  v_sub_f32 v53, v58, v60
  v_exp_f32 v53, v53
  v_exp_f32 v24, v24
  v_exp_f32 v25, v25
  v_exp_f32 v26, v26
  v_exp_f32 v27, v27
  v_exp_f32 v28, v28
  v_exp_f32 v29, v29
  v_exp_f32 v30, v30
  v_exp_f32 v31, v31
  v_cndmask_b32_dpp v54, v53, v53, vcc row_ror:8 row_mask:0xf bank_mask:0xf
  v_pk_add_f32 v[40:41], v[24:25], v[26:27]
  v_pk_add_f32 v[62:63], v[28:29], v[30:31]
  v_pk_add_f32 v[62:63], v[40:41], v[62:63]
  v_fma_f32 v56, v56, v53, v62
  v_fma_f32 v57, v57, v53, v63
  v_cvt_pk_bf16_f32 v24, v24, v24
  v_cvt_pk_bf16_f32 v25, v25, v25
  v_cvt_pk_bf16_f32 v26, v26, v26
  v_cvt_pk_bf16_f32 v27, v27, v27
  v_cvt_pk_bf16_f32 v28, v28, v28
  v_cvt_pk_bf16_f32 v29, v29, v29
  v_cvt_pk_bf16_f32 v30, v30, v30
  v_cvt_pk_bf16_f32 v31, v31, v31
  s_setprio 1
  s_waitcnt vmcnt(11)
  buffer_load_dwordx4 v[160:163], v1, s[16:19], s43 offen offset:0 nt
  s_waitcnt vmcnt(11)
  buffer_load_dwordx4 v[164:167], v1, s[16:19], s43 offen offset:1024 nt
  s_waitcnt vmcnt(11)
  buffer_load_dwordx4 v[168:171], v1, s[16:19], s43 offen offset:2048 nt
  s_waitcnt vmcnt(11)
  buffer_load_dwordx4 v[172:175], v1, s[16:19], s43 offen offset:3072 nt
  s_add_u32 s43, s43, s41
  v_mul_f32 v48, v54, v48
  v_mul_f32 v49, v54, v49
  v_mul_f32 v50, v54, v50
  v_mul_f32 v51, v54, v51
  v_and_b32 v40, v24, v4
  v_and_b32 v41, v24, v5
  v_and_b32 v42, v24, v6
  v_and_b32 v43, v24, v7
  v_and_b32 v44, v25, v4
  v_and_b32 v45, v25, v5
  v_and_b32 v46, v25, v6
  v_and_b32 v47, v25, v7
  v_mfma_f32_16x16x32_bf16 v[48:51], v[40:43], v[96:99], v[48:51]
  v_and_b32 v40, v26, v4
  v_and_b32 v41, v26, v5
  v_and_b32 v42, v26, v6
  v_and_b32 v43, v26, v7
  v_mfma_f32_16x16x32_bf16 v[48:51], v[44:47], v[100:103], v[48:51]
  v_and_b32 v44, v27, v4
  v_and_b32 v45, v27, v5
  v_and_b32 v46, v27, v6
  v_and_b32 v47, v27, v7
  v_mfma_f32_16x16x32_bf16 v[48:51], v[40:43], v[104:107], v[48:51]
  s_nop 0
  v_mfma_f32_16x16x32_bf16 v[48:51], v[44:47], v[108:111], v[48:51]
  s_cmp_lg_u32 s9, 0
  s_cbranch_scc1 L_pf3
  s_cmp_ge_u32 s7, 72
  s_cbranch_scc1 L_pf3
  s_mov_b64 exec, 0xffff
  s_waitcnt vmcnt(8)
L_pf2:
  v_cmp_ne_u32 s[60:61], s38, v248
  s_cmp_eq_u64 s[60:61], 0
  s_cbranch_scc1 L_pf4
  buffer_load_dword v248, v249, s[28:31], s59 offen sc1
  s_waitcnt vmcnt(0)
  s_addk_i32 s47, -1
  s_cmpk_gt_i32 s47, 0
  s_cbranch_scc1 L_pf2
L_pf4:
  s_mov_b64 exec, -1
L_pf3:
  s_waitcnt vmcnt(11)
  buffer_load_dwordx4 v[176:179], v1, s[16:19], s43 offen offset:0 nt
  s_waitcnt vmcnt(11)
  buffer_load_dwordx4 v[180:183], v1, s[16:19], s43 offen offset:1024 nt
  s_waitcnt vmcnt(11)
  buffer_load_dwordx4 v[184:187], v1, s[16:19], s43 offen offset:2048 nt
  s_waitcnt vmcnt(11)
  buffer_load_dwordx4 v[188:191], v1, s[16:19], s43 offen offset:3072 nt
  v_mfma_f32_16x16x32_bf16 v[32:35], v[112:115], v[8:11], 0
  v_mfma_f32_16x16x32_bf16 v[32:35], v[116:119], v[12:15], v[32:35]
  v_mfma_f32_16x16x32_bf16 v[32:35], v[120:123], v[16:19], v[32:35]
  v_mfma_f32_16x16x32_bf16 v[32:35], v[124:127], v[20:23], v[32:35]
  v_and_b32 v40, v28, v4
  v_and_b32 v41, v28, v5
  v_and_b32 v42, v28, v6
  v_and_b32 v43, v28, v7
  v_and_b32 v44, v29, v4
  v_and_b32 v45, v29, v5
  v_and_b32 v46, v29, v6
  v_and_b32 v47, v29, v7
  v_mfma_f32_16x16x32_bf16 v[48:51], v[40:43], v[128:131], v[48:51]
  v_and_b32 v40, v30, v4
  v_and_b32 v41, v30, v5
  v_and_b32 v42, v30, v6
  v_and_b32 v43, v30, v7
  v_mfma_f32_16x16x32_bf16 v[48:51], v[44:47], v[132:135], v[48:51]
  v_and_b32 v44, v31, v4
  v_and_b32 v45, v31, v5
  v_and_b32 v46, v31, v6
  v_and_b32 v47, v31, v7
  v_mfma_f32_16x16x32_bf16 v[48:51], v[40:43], v[136:139], v[48:51]
  s_nop 0
  v_mfma_f32_16x16x32_bf16 v[48:51], v[44:47], v[140:143], v[48:51]
  s_waitcnt vmcnt(8)
  v_mfma_f32_16x16x32_bf16 v[36:39], v[144:147], v[8:11], 0
  v_mfma_f32_16x16x32_bf16 v[36:39], v[148:151], v[12:15], v[36:39]
  v_mfma_f32_16x16x32_bf16 v[36:39], v[152:155], v[16:19], v[36:39]
  v_mfma_f32_16x16x32_bf16 v[36:39], v[156:159], v[20:23], v[36:39]
  v_max3_f32 v55, v32, v33, v34
  v_max3_f32 v52, v52, v35, v55
  s_nop 5
  v_max3_f32 v55, v36, v37, v38
  v_max3_f32 v52, v52, v39, v55
  v_mov_b32 v55, v52
  s_nop 1
  v_permlane16_swap_b32 v52, v55
  v_max_f32 v52, v52, v55
  v_mov_b32 v55, v52
  s_nop 1
  v_permlane32_swap_b32 v52, v55
  v_max_f32 v52, v52, v55
  v_mul_f32 v60, 0xbe0293ee, v52
  v_fma_f32 v32, v32, s40, v60
  v_fma_f32 v33, v33, s40, v60
  v_fma_f32 v34, v34, s40, v60
  v_fma_f32 v35, v35, s40, v60
  v_fma_f32 v36, v36, s40, v60
  v_fma_f32 v37, v37, s40, v60
  v_fma_f32 v38, v38, s40, v60
  v_fma_f32 v39, v39, s40, v60
  v_sub_f32 v53, v60, v58
  v_exp_f32 v53, v53
  v_exp_f32 v32, v32
  v_exp_f32 v33, v33
  v_exp_f32 v34, v34
  v_exp_f32 v35, v35
  v_exp_f32 v36, v36
  v_exp_f32 v37, v37
  v_exp_f32 v38, v38
  v_exp_f32 v39, v39
  v_cndmask_b32_dpp v54, v53, v53, vcc row_ror:8 row_mask:0xf bank_mask:0xf
  v_pk_add_f32 v[40:41], v[32:33], v[34:35]
  v_pk_add_f32 v[62:63], v[36:37], v[38:39]
  v_pk_add_f32 v[62:63], v[40:41], v[62:63]
  v_fma_f32 v56, v56, v53, v62
  v_fma_f32 v57, v57, v53, v63
  v_cvt_pk_bf16_f32 v32, v32, v32
  v_cvt_pk_bf16_f32 v33, v33, v33
  v_cvt_pk_bf16_f32 v34, v34, v34
  v_cvt_pk_bf16_f32 v35, v35, v35
  v_cvt_pk_bf16_f32 v36, v36, v36
  v_cvt_pk_bf16_f32 v37, v37, v37
  v_cvt_pk_bf16_f32 v38, v38, v38
  v_cvt_pk_bf16_f32 v39, v39, v39
  v_add_f32 v61, v56, v57
  v_mov_b32 v55, v61
  s_nop 1
  v_permlane16_swap_b32 v61, v55
  v_add_f32 v61, v61, v55
  v_mov_b32 v55, v61
  s_nop 1
  v_permlane32_swap_b32 v61, v55
  v_add_f32 v61, v61, v55
  ds_write_b64 v225, v[60:61] offset:1280
  s_setprio 0
  s_setprio 1
  s_cmp_gt_u32 s49, 5
  s_cbranch_scc1 L_B67
  v_mul_f32 v48, v54, v48
  v_mul_f32 v49, v54, v49
  v_mul_f32 v50, v54, v50
  v_mul_f32 v51, v54, v51
  s_waitcnt vmcnt(4)
  v_and_b32 v40, v32, v4
  v_and_b32 v41, v32, v5
  v_and_b32 v42, v32, v6
  v_and_b32 v43, v32, v7
  v_and_b32 v44, v33, v4
  v_and_b32 v45, v33, v5
  v_and_b32 v46, v33, v6
  v_and_b32 v47, v33, v7
  v_mfma_f32_16x16x32_bf16 v[48:51], v[40:43], v[160:163], v[48:51]
  v_and_b32 v40, v34, v4
  v_and_b32 v41, v34, v5
  v_and_b32 v42, v34, v6
  v_and_b32 v43, v34, v7
  v_mfma_f32_16x16x32_bf16 v[48:51], v[44:47], v[164:167], v[48:51]
  v_and_b32 v44, v35, v4
  v_and_b32 v45, v35, v5
  v_and_b32 v46, v35, v6
  v_and_b32 v47, v35, v7
  v_mfma_f32_16x16x32_bf16 v[48:51], v[40:43], v[168:171], v[48:51]
  s_nop 0
  v_mfma_f32_16x16x32_bf16 v[48:51], v[44:47], v[172:175], v[48:51]
  v_and_b32 v40, v36, v4
  v_and_b32 v41, v36, v5
  v_and_b32 v42, v36, v6
  v_and_b32 v43, v36, v7
  v_and_b32 v44, v37, v4
  v_and_b32 v45, v37, v5
  v_and_b32 v46, v37, v6
  v_and_b32 v47, v37, v7
  s_waitcnt vmcnt(3)
  v_mfma_f32_16x16x32_bf16 v[48:51], v[40:43], v[176:179], v[48:51]
  v_and_b32 v40, v38, v4
  v_and_b32 v41, v38, v5
  v_and_b32 v42, v38, v6
  v_and_b32 v43, v38, v7
  s_waitcnt vmcnt(2)
  v_mfma_f32_16x16x32_bf16 v[48:51], v[44:47], v[180:183], v[48:51]
  v_and_b32 v44, v39, v4
  v_and_b32 v45, v39, v5
  v_and_b32 v46, v39, v6
  v_and_b32 v47, v39, v7
  s_waitcnt vmcnt(1)
  v_mfma_f32_16x16x32_bf16 v[48:51], v[40:43], v[184:187], v[48:51]
  s_waitcnt vmcnt(0)
  v_mfma_f32_16x16x32_bf16 v[48:51], v[44:47], v[188:191], v[48:51]
  s_nop 7
  ds_write_b128 v224, v[48:51] offset:2048
  s_cmp_eq_u32 s9, 0
  s_cbranch_scc1 L_c3
L_bf3:
  s_setprio 0
  buffer_load_dwordx4 v[192:195], v226, s[24:27], s45 offen offset:0 nt
  buffer_load_dwordx4 v[196:199], v226, s[24:27], s45 offen offset:1152 nt
  buffer_load_dwordx4 v[200:203], v226, s[24:27], s45 offen offset:2304 nt
  buffer_load_dwordx4 v[204:207], v226, s[24:27], s45 offen offset:3456 nt
  buffer_load_dwordx4 v[208:211], v226, s[24:27], s46 offen offset:0 nt
  buffer_load_dwordx4 v[212:215], v226, s[24:27], s46 offen offset:1152 nt
  buffer_load_dwordx4 v[216:219], v226, s[24:27], s46 offen offset:2304 nt
  buffer_load_dwordx4 v[220:223], v226, s[24:27], s46 offen offset:3456 nt
  s_setprio 1
  s_waitcnt lgkmcnt(0)
  s_barrier
  v_and_b32 v55, 0x30, v0
  v_and_b32 v59, 3, v0
  v_lshl_or_b32 v55, v59, 2, v55
  v_and_b32 v59, 4, v0
  v_lshl_or_b32 v55, v59, 4, v55
  v_and_b32 v59, 8, v0
  v_lshl_or_b32 v55, v59, 6, v55
  v_add_u32 v55, 10240, v55
  v_lshlrev_b32 v59, 1, v59
  s_waitcnt vmcnt(0)
  s_barrier
  ds_read2_b32 v[232:233], v55 offset0:0 offset1:32
  ds_read_b128 v[236:239], v59 offset:1472
  ds_read2_b32 v[234:235], v55 offset0:64 offset1:96
  s_waitcnt lgkmcnt(1)
  v_pk_mul_f32 v[232:233], v[232:233], v[236:237]
  s_waitcnt lgkmcnt(0)
  v_pk_fma_f32 v[232:233], v[234:235], v[238:239], v[232:233]
  v_add_f32 v232, v232, v233
  s_nop 1
  v_add_f32_dpp v232, v232, v232 row_ror:8 row_mask:0xf bank_mask:0xf
  v_cvt_pk_bf16_f32 v8, v232, v232
  s_nop 1
  v_and_b32_dpp v40, v8, v4 row_newbcast:0 row_mask:0xf bank_mask:0xf
  v_and_b32_dpp v41, v8, v5 row_newbcast:0 row_mask:0xf bank_mask:0xf
  v_and_b32_dpp v42, v8, v6 row_newbcast:0 row_mask:0xf bank_mask:0xf
  v_and_b32_dpp v43, v8, v7 row_newbcast:0 row_mask:0xf bank_mask:0xf
  v_and_b32_dpp v44, v8, v4 row_newbcast:1 row_mask:0xf bank_mask:0xf
  v_and_b32_dpp v45, v8, v5 row_newbcast:1 row_mask:0xf bank_mask:0xf
  v_and_b32_dpp v46, v8, v6 row_newbcast:1 row_mask:0xf bank_mask:0xf
  v_and_b32_dpp v47, v8, v7 row_newbcast:1 row_mask:0xf bank_mask:0xf
  v_mfma_f32_16x16x32_bf16 v[48:51], v[40:43], v[192:195], 0
  v_and_b32_dpp v40, v8, v4 row_newbcast:2 row_mask:0xf bank_mask:0xf
  v_and_b32_dpp v41, v8, v5 row_newbcast:2 row_mask:0xf bank_mask:0xf
  v_and_b32_dpp v42, v8, v6 row_newbcast:2 row_mask:0xf bank_mask:0xf
  v_and_b32_dpp v43, v8, v7 row_newbcast:2 row_mask:0xf bank_mask:0xf
  v_mfma_f32_16x16x32_bf16 v[48:51], v[44:47], v[196:199], v[48:51]
  v_and_b32_dpp v44, v8, v4 row_newbcast:3 row_mask:0xf bank_mask:0xf
  v_and_b32_dpp v45, v8, v5 row_newbcast:3 row_mask:0xf bank_mask:0xf
  v_and_b32_dpp v46, v8, v6 row_newbcast:3 row_mask:0xf bank_mask:0xf
  v_and_b32_dpp v47, v8, v7 row_newbcast:3 row_mask:0xf bank_mask:0xf
  v_mfma_f32_16x16x32_bf16 v[48:51], v[40:43], v[200:203], v[48:51]
  v_and_b32_dpp v40, v8, v4 row_newbcast:4 row_mask:0xf bank_mask:0xf
  v_and_b32_dpp v41, v8, v5 row_newbcast:4 row_mask:0xf bank_mask:0xf
  v_and_b32_dpp v42, v8, v6 row_newbcast:4 row_mask:0xf bank_mask:0xf
  v_and_b32_dpp v43, v8, v7 row_newbcast:4 row_mask:0xf bank_mask:0xf
  v_mfma_f32_16x16x32_bf16 v[48:51], v[44:47], v[204:207], v[48:51]
  v_and_b32_dpp v44, v8, v4 row_newbcast:5 row_mask:0xf bank_mask:0xf
  v_and_b32_dpp v45, v8, v5 row_newbcast:5 row_mask:0xf bank_mask:0xf
  v_and_b32_dpp v46, v8, v6 row_newbcast:5 row_mask:0xf bank_mask:0xf
  v_and_b32_dpp v47, v8, v7 row_newbcast:5 row_mask:0xf bank_mask:0xf
  v_mfma_f32_16x16x32_bf16 v[48:51], v[40:43], v[208:211], v[48:51]
  v_and_b32_dpp v40, v8, v4 row_newbcast:6 row_mask:0xf bank_mask:0xf
  v_and_b32_dpp v41, v8, v5 row_newbcast:6 row_mask:0xf bank_mask:0xf
  v_and_b32_dpp v42, v8, v6 row_newbcast:6 row_mask:0xf bank_mask:0xf
  v_and_b32_dpp v43, v8, v7 row_newbcast:6 row_mask:0xf bank_mask:0xf
  v_mfma_f32_16x16x32_bf16 v[48:51], v[44:47], v[212:215], v[48:51]
  v_and_b32_dpp v44, v8, v4 row_newbcast:7 row_mask:0xf bank_mask:0xf
  v_and_b32_dpp v45, v8, v5 row_newbcast:7 row_mask:0xf bank_mask:0xf
  v_and_b32_dpp v46, v8, v6 row_newbcast:7 row_mask:0xf bank_mask:0xf
  v_and_b32_dpp v47, v8, v7 row_newbcast:7 row_mask:0xf bank_mask:0xf
  v_mfma_f32_16x16x32_bf16 v[48:51], v[40:43], v[216:219], v[48:51]
  s_nop 0
  v_mfma_f32_16x16x32_bf16 v[48:51], v[44:47], v[220:223], v[48:51]
  s_cbranch_execz L_t4b
  s_mov_b64 exec, s[50:51]
  s_nop 5
  buffer_store_dwordx4 v[48:51], v229, s[28:31], s4 offen sc1
  s_waitcnt vmcnt(0)
  s_barrier
  s_endpgm
P_c3:
  s_branch L_hopret
L_c3:
  v_lshrrev_b32 v55, 5, v0
  v_lshlrev_b32 v228, 6, v55
  s_mov_b64 exec, 0xff
  v_cmp_ne_u32 s[50:51], s62, v252
  s_mov_b64 exec, -1
  ds_read_b128 v[232:235], v228 offset:1280
  ds_read_b128 v[236:239], v228 offset:1296
  ds_read_b128 v[240:243], v228 offset:1312
  ds_read_b128 v[244:247], v228 offset:1328
  v_bfe_u32 v59, v0, 2, 2
  v_lshl_or_b32 v59, v55, 2, v59
  v_lshlrev_b32 v229, 11, v59
  v_cmp_eq_u32 s[52:53], s6, v59
  v_and_b32 v59, 3, v0
  v_lshl_or_b32 v227, v59, 4, v229
  v_lshlrev_b32 v229, 4, v59
  v_lshl_or_b32 v229, v55, 6, v229
  v_and_b32 v59, 16, v0
  v_lshl_or_b32 v227, v59, 2, v227
  s_lshl_b32 s69, s8, 7
  s_add_u32 s69, s69, 196608
  s_and_b32 s48, s8, 0xf8
  s_lshl_b32 s48, s48, 11
  s_add_u32 s48, s48, 262144
  s_lshl_b32 s10, s6, 3
  s_add_u32 s4, s48, s10
  s_lshl_b32 s10, s6, 7
  s_add_u32 s48, s48, s10
L_c3w:
  s_waitcnt lgkmcnt(0)
  v_max3_u32 v55, v233, v235, v237
  v_max3_u32 v62, v239, v241, v243
  v_max3_u32 v55, v55, v245, v247
  v_max_u32 v55, v55, v62
  v_cmp_eq_u32 vcc, -1, v55
  s_cbranch_vccz L_c3ok
  ds_read_b128 v[232:235], v228 offset:1280
  ds_read_b128 v[236:239], v228 offset:1296
  ds_read_b128 v[240:243], v228 offset:1312
  ds_read_b128 v[244:247], v228 offset:1328
  s_addk_i32 s47, -1
  s_cmpk_gt_i32 s47, 0
  s_cbranch_scc1 L_c3w
  s_waitcnt lgkmcnt(0)
L_c3ok:
  v_min3_f32 v62, v232, v234, v236
  v_min3_f32 v55, v238, v240, v242
  v_min3_f32 v62, v62, v244, v246
  v_min_f32 v62, v62, v55
  v_sub_f32 v232, v62, v232
  v_sub_f32 v234, v62, v234
  v_sub_f32 v236, v62, v236
  v_sub_f32 v238, v62, v238
  v_sub_f32 v240, v62, v240
  v_sub_f32 v242, v62, v242
  v_sub_f32 v244, v62, v244
  v_sub_f32 v246, v62, v246
  v_exp_f32 v232, v232
  v_exp_f32 v234, v234
  v_exp_f32 v236, v236
  v_exp_f32 v238, v238
  v_exp_f32 v240, v240
  v_exp_f32 v242, v242
  v_exp_f32 v244, v244
  v_exp_f32 v246, v246
  v_mul_f32 v63, v232, v233
  v_fmac_f32 v63, v234, v235
  v_fmac_f32 v63, v236, v237
  v_fmac_f32 v63, v238, v239
  v_fmac_f32 v63, v240, v241
  v_fmac_f32 v63, v242, v243
  v_fmac_f32 v63, v244, v245
  v_fmac_f32 v63, v246, v247
  v_mov_b32 v24, v62
  v_mov_b32 v25, v63
  v_mov_b32 v26, v62
  v_mov_b32 v27, v63
  s_mov_b32 exec_lo, 15
  s_mov_b32 exec_hi, 15
  s_cmp_eq_u64 s[50:51], 0
  s_cbranch_scc1 L_hs0a
  buffer_store_dwordx4 v[24:27], v229, s[28:31], s69 offen sc1
  s_branch L_hs0b
L_hs0a:
  buffer_store_dwordx4 v[24:27], v229, s[28:31], s69 offen
L_hs0b:
  ds_write_b128 v229, v[24:27] offset:1536
  s_mov_b64 exec, -1
  s_lshl_b32 s10, s6, 7
  v_and_b32 v250, 0x7f, v227
  v_or_b32 v250, s10, v250
  s_waitcnt lgkmcnt(0)
  s_barrier
L_t2b:
  ds_read_b128 v[176:179], v1 offset:2048
  ds_read_b128 v[180:183], v1 offset:3072
  ds_read_b128 v[184:187], v1 offset:4096
  ds_read_b128 v[188:191], v1 offset:5120
  ds_read_b128 v[160:163], v1 offset:6144
  ds_read_b128 v[164:167], v1 offset:7168
  ds_read_b128 v[168:171], v1 offset:8192
  ds_read_b128 v[172:175], v1 offset:9216
  s_waitcnt lgkmcnt(6)
  v_pk_mul_f32 v[48:49], v[176:177], v[232:233] op_sel_hi:[1,0]
  v_pk_mul_f32 v[50:51], v[178:179], v[232:233] op_sel_hi:[1,0]
  v_pk_fma_f32 v[48:49], v[180:181], v[234:235], v[48:49] op_sel_hi:[1,0,1]
  v_pk_fma_f32 v[50:51], v[182:183], v[234:235], v[50:51] op_sel_hi:[1,0,1]
  s_waitcnt lgkmcnt(4)
  v_pk_fma_f32 v[48:49], v[184:185], v[236:237], v[48:49] op_sel_hi:[1,0,1]
  v_pk_fma_f32 v[50:51], v[186:187], v[236:237], v[50:51] op_sel_hi:[1,0,1]
  v_pk_fma_f32 v[48:49], v[188:189], v[238:239], v[48:49] op_sel_hi:[1,0,1]
  v_pk_fma_f32 v[50:51], v[190:191], v[238:239], v[50:51] op_sel_hi:[1,0,1]
  s_waitcnt lgkmcnt(2)
  v_pk_fma_f32 v[48:49], v[160:161], v[240:241], v[48:49] op_sel_hi:[1,0,1]
  v_pk_fma_f32 v[50:51], v[162:163], v[240:241], v[50:51] op_sel_hi:[1,0,1]
  v_pk_fma_f32 v[48:49], v[164:165], v[242:243], v[48:49] op_sel_hi:[1,0,1]
  v_pk_fma_f32 v[50:51], v[166:167], v[242:243], v[50:51] op_sel_hi:[1,0,1]
  s_waitcnt lgkmcnt(0)
  v_pk_fma_f32 v[48:49], v[168:169], v[244:245], v[48:49] op_sel_hi:[1,0,1]
  v_pk_fma_f32 v[50:51], v[170:171], v[244:245], v[50:51] op_sel_hi:[1,0,1]
  v_pk_fma_f32 v[48:49], v[172:173], v[246:247], v[48:49] op_sel_hi:[1,0,1]
  v_pk_fma_f32 v[50:51], v[174:175], v[246:247], v[50:51] op_sel_hi:[1,0,1]
  s_cmp_eq_u64 s[50:51], 0
  s_cbranch_scc1 L_hs1a
  buffer_store_dwordx4 v[48:51], v227, s[28:31], s48 offen sc1
  s_branch L_hs1b
L_hs1a:
  buffer_store_dwordx4 v[48:51], v227, s[28:31], s48 offen
L_hs1b:
  s_mov_b64 exec, s[52:53]
  ds_write_b128 v250, v[48:51] offset:10240
  s_waitcnt lgkmcnt(0)
  s_barrier
  s_endpgm
P_B67:
  s_branch L_hopret
L_B67:
  v_lshrrev_b32 v55, 4, v0
  v_and_b32 v59, 1, v0
  v_lshlrev_b32 v55, 1, v55
  v_lshl_or_b32 v230, v59, 3, v55
  s_lshl_b32 s52, s8, 12
  s_add_u32 s52, s52, 1048576
  s_lshr_b32 s53, s8, 7
  s_mul_i32 s53, s53, 1152
  s_lshl_b32 s10, s7, 4
  s_add_u32 s53, s53, s10
  v_add_u32 v230, s53, v230
  s_and_b32 s58, s8, 0x80
  s_add_u32 s58, s58, 65536
  s_load_dword s38, s[28:29], s58
  v_mov_b32 v229, s58
  v_lshrrev_b32 v55, 1, v0
  v_mul_u32_u24 v227, 2304, v55
  v_lshl_or_b32 v227, v59, 6, v227
  s_and_b32 s10, s8, 0x80
  s_mul_i32 s10, s10, 2304
  s_add_u32 s10, s10, 1048576
  s_and_b32 s11, s7, 3
  s_lshl_b32 s11, s11, 4
  s_add_u32 s10, s10, s11
  s_lshr_b32 s11, s7, 2
  s_lshl_b32 s11, s11, 7
  s_add_u32 s52, s10, s11
  s_add_u32 s53, s52, 73728
  s_add_u32 s54, s52, 147456
  s_add_u32 s55, s52, 221184
  s_lshl_b32 s10, s6, 3
  s_lshl_b64 s[60:61], 0xff, s10
  s_not_b64 s[60:61], s[60:61]
  v_and_b32 v55, 7, v0
  v_lshlrev_b32 v228, 7, v55
  v_lshlrev_b32 v250, 2, v55
  s_and_b32 s10, s8, 4
  s_lshl_b32 s10, s10, 4
  v_mov_b32 v251, s10
  v_cmp_ne_u32 s[62:63], s6, v55
  v_mul_f32 v48, v54, v48
  v_mul_f32 v49, v54, v49
  v_mul_f32 v50, v54, v50
  v_mul_f32 v51, v54, v51
  s_waitcnt vmcnt(4)
  v_and_b32 v40, v32, v4
  v_and_b32 v41, v32, v5
  v_and_b32 v42, v32, v6
  v_and_b32 v43, v32, v7
  v_and_b32 v44, v33, v4
  v_and_b32 v45, v33, v5
  v_and_b32 v46, v33, v6
  v_and_b32 v47, v33, v7
  v_mfma_f32_16x16x32_bf16 v[48:51], v[40:43], v[160:163], v[48:51]
  v_and_b32 v40, v34, v4
  v_and_b32 v41, v34, v5
  v_and_b32 v42, v34, v6
  v_and_b32 v43, v34, v7
  v_mfma_f32_16x16x32_bf16 v[48:51], v[44:47], v[164:167], v[48:51]
  v_and_b32 v44, v35, v4
  v_and_b32 v45, v35, v5
  v_and_b32 v46, v35, v6
  v_and_b32 v47, v35, v7
  v_mfma_f32_16x16x32_bf16 v[48:51], v[40:43], v[168:171], v[48:51]
  s_nop 0
  v_mfma_f32_16x16x32_bf16 v[48:51], v[44:47], v[172:175], v[48:51]
  v_and_b32 v40, v36, v4
  v_and_b32 v41, v36, v5
  v_and_b32 v42, v36, v6
  v_and_b32 v43, v36, v7
  v_and_b32 v44, v37, v4
  v_and_b32 v45, v37, v5
  v_and_b32 v46, v37, v6
  v_and_b32 v47, v37, v7
  s_waitcnt vmcnt(3)
  v_mfma_f32_16x16x32_bf16 v[48:51], v[40:43], v[176:179], v[48:51]
  v_and_b32 v40, v38, v4
  v_and_b32 v41, v38, v5
  v_and_b32 v42, v38, v6
  v_and_b32 v43, v38, v7
  s_waitcnt vmcnt(2)
  v_mfma_f32_16x16x32_bf16 v[48:51], v[44:47], v[180:183], v[48:51]
  v_and_b32 v44, v39, v4
  v_and_b32 v45, v39, v5
  v_and_b32 v46, v39, v6
  v_and_b32 v47, v39, v7
  s_waitcnt vmcnt(1)
  v_mfma_f32_16x16x32_bf16 v[48:51], v[40:43], v[184:187], v[48:51]
  s_waitcnt vmcnt(0)
  v_mfma_f32_16x16x32_bf16 v[48:51], v[44:47], v[188:191], v[48:51]
  s_nop 7
  ds_write_b128 v224, v[48:51] offset:2048
  s_waitcnt lgkmcnt(0)
  s_barrier
  s_cmp_eq_u32 s49, 6
  s_cbranch_scc1 L_w6
  s_mov_b64 exec, s[60:61]
  buffer_load_dwordx4 v[176:179], v1, s[28:31], s48 offen sc1
  buffer_load_dwordx4 v[180:183], v1, s[28:31], s48 offen sc1
  buffer_load_dwordx4 v[184:187], v1, s[28:31], s48 offen sc1
L_pw:
  s_waitcnt vmcnt(2)
  v_max3_u32 v55, v176, v177, v178
  v_max_u32 v55, v55, v179
  v_cmp_ne_u32 vcc, -1, v55
  s_cbranch_vccz L_pw0
  s_mov_b64 exec, vcc
  ds_write_b128 v1, v[176:179] offset:10240
  s_andn2_b64 s[60:61], s[60:61], vcc
  s_cbranch_scc0 L_pwd
  s_mov_b64 exec, s[60:61]
L_pw0:
  buffer_load_dwordx4 v[176:179], v1, s[28:31], s48 offen sc1
  s_waitcnt vmcnt(2)
  v_max3_u32 v55, v180, v181, v182
  v_max_u32 v55, v55, v183
  v_cmp_ne_u32 vcc, -1, v55
  s_cbranch_vccz L_pw1
  s_mov_b64 exec, vcc
  ds_write_b128 v1, v[180:183] offset:10240
  s_andn2_b64 s[60:61], s[60:61], vcc
  s_cbranch_scc0 L_pwd
  s_mov_b64 exec, s[60:61]
L_pw1:
  buffer_load_dwordx4 v[180:183], v1, s[28:31], s48 offen sc1
  s_waitcnt vmcnt(2)
  v_max3_u32 v55, v184, v185, v186
  v_max_u32 v55, v55, v187
  v_cmp_ne_u32 vcc, -1, v55
  s_cbranch_vccz L_pw2
  s_mov_b64 exec, vcc
  ds_write_b128 v1, v[184:187] offset:10240
  s_andn2_b64 s[60:61], s[60:61], vcc
  s_cbranch_scc0 L_pwd
  s_mov_b64 exec, s[60:61]
L_pw2:
  buffer_load_dwordx4 v[184:187], v1, s[28:31], s48 offen sc1
  s_addk_i32 s47, -1
  s_cmpk_gt_i32 s47, 0
  s_cbranch_scc1 L_pw
L_pwd:
  s_waitcnt lgkmcnt(0)
  s_barrier
  s_waitcnt vmcnt(0)
  s_endpgm
P_w6:
  s_branch L_hopret
L_w6:
  s_not_b64 exec, s[62:63]
  ds_read_b64 v[232:233], v251 offset:1536
  s_mov_b64 exec, s[62:63]
L_ml6:
  buffer_load_dwordx2 v[232:233], v228, s[28:31], s69 offen sc1
L_ml6w:
  s_waitcnt vmcnt(0)
  v_max_u32 v55, v232, v233
  v_cmp_eq_u32 vcc, -1, v55
  s_cbranch_vccz L_ml6ok
  s_addk_i32 s47, -1
  s_cmpk_gt_i32 s47, 0
  s_cbranch_scc1 L_ml6
L_ml6ok:
  s_mov_b64 exec, -1
  s_waitcnt lgkmcnt(0)
  v_min_f32_dpp v55, v232, v232 row_ror:4 row_mask:0xf bank_mask:0xf
  s_nop 1
  v_min_f32_dpp v55, v55, v55 row_ror:2 row_mask:0xf bank_mask:0xf
  s_nop 1
  v_min_f32_dpp v55, v55, v55 row_ror:1 row_mask:0xf bank_mask:0xf
  v_sub_f32 v55, v55, v232
  v_exp_f32 v232, v55
  s_nop 0
  v_mul_f32 v233, v232, v233
  s_nop 1
  v_add_f32_dpp v55, v233, v233 row_ror:4 row_mask:0xf bank_mask:0xf
  s_nop 1
  v_add_f32_dpp v55, v55, v55 row_ror:2 row_mask:0xf bank_mask:0xf
  s_nop 1
  v_add_f32_dpp v55, v55, v55 row_ror:1 row_mask:0xf bank_mask:0xf
  v_rcp_f32 v55, v55
  s_mov_b64 exec, 0xff
  v_mul_f32 v232, v232, v55
  ds_write_b32 v250, v232 offset:1472
  s_waitcnt lgkmcnt(0)
  s_mov_b64 exec, -1
  s_barrier
  s_cmp_lg_u32 s49, 6
  s_cbranch_scc1 L_fin
  s_cmp_ge_u32 s7, 72
  s_cbranch_scc1 L_fin
  s_barrier
L_t4b:
  s_cbranch_execz L_t4c
  buffer_load_dwordx4 v[176:179], v227, s[28:31], s52 offen sc1
  buffer_load_dwordx4 v[180:183], v227, s[28:31], s53 offen sc1
  buffer_load_dwordx4 v[184:187], v227, s[28:31], s54 offen sc1
  buffer_load_dwordx4 v[188:191], v227, s[28:31], s55 offen sc1
L_h2:
  s_waitcnt vmcnt(0)
  v_max3_u32 v40, v176, v177, v178
  v_max3_u32 v41, v180, v181, v182
  v_max3_u32 v42, v184, v185, v186
  v_max3_u32 v43, v188, v189, v190
  v_max_u32 v40, v40, v179
  v_max_u32 v41, v41, v183
  v_max_u32 v42, v42, v187
  v_max_u32 v43, v43, v191
  v_cmp_eq_u32 s[60:61], -1, v40
  v_cmp_eq_u32 s[62:63], -1, v41
  v_cmp_eq_u32 s[64:65], -1, v42
  v_cmp_eq_u32 s[66:67], -1, v43
  s_or_b64 vcc, s[60:61], s[62:63]
  s_or_b64 exec, s[64:65], s[66:67]
  s_or_b64 exec, exec, vcc
  s_cbranch_scc0 L_h2_got
  s_mov_b64 exec, s[60:61]
  s_cbranch_execz L_h2_0
  buffer_load_dwordx4 v[176:179], v227, s[28:31], s52 offen sc1
L_h2_0:
  s_mov_b64 exec, s[62:63]
  s_cbranch_execz L_h2_1
  buffer_load_dwordx4 v[180:183], v227, s[28:31], s53 offen sc1
L_h2_1:
  s_mov_b64 exec, s[64:65]
  s_cbranch_execz L_h2_2
  buffer_load_dwordx4 v[184:187], v227, s[28:31], s54 offen sc1
L_h2_2:
  s_mov_b64 exec, s[66:67]
  s_cbranch_execz L_h2_3
  buffer_load_dwordx4 v[188:191], v227, s[28:31], s55 offen sc1
L_h2_3:
  s_mov_b64 exec, -1
  s_addk_i32 s47, -1
  s_cmpk_gt_i32 s47, 0
  s_cbranch_scc1 L_h2
  s_waitcnt vmcnt(0)
L_h2_got:
  s_mov_b64 exec, -1
L_t4c:
  v_pk_add_f32 v[176:177], v[176:177], v[180:181]
  v_pk_add_f32 v[178:179], v[178:179], v[182:183]
  v_pk_add_f32 v[184:185], v[184:185], v[188:189]
  v_pk_add_f32 v[186:187], v[186:187], v[190:191]
  v_pk_add_f32 v[176:177], v[176:177], v[184:185]
  v_pk_add_f32 v[178:179], v[178:179], v[186:187]
  s_nop 1
  v_permlane32_swap_b32 v176, v178
  v_permlane32_swap_b32 v177, v179
  v_add_f32 v176, v176, v178
  v_add_f32 v177, v177, v179
  s_nop 1
  v_permlane16_swap_b32 v176, v177
  v_add_f32 v176, v176, v177
  s_nop 1
  v_add_f32_dpp v176, v176, v176 row_ror:2 row_mask:0xf bank_mask:0xf
  s_nop 1
  v_add_f32_dpp v176, v176, v176 row_ror:4 row_mask:0xf bank_mask:0xf
  s_nop 1
  v_add_f32_dpp v176, v176, v176 row_ror:8 row_mask:0xf bank_mask:0xf
  v_cvt_pk_bf16_f32 v176, v176, v176
  s_mov_b32 exec_lo, 0x30003
  s_mov_b32 exec_hi, 0x30003
  global_store_short v230, v176, s[32:33]
  s_cmp_lg_u32 s7, 0
  s_cbranch_scc1 L_fin
  s_add_u32 s38, s38, 2654435769
  v_mov_b32 v177, s38
  s_mov_b64 exec, 1
  global_store_dword v229, v177, s[28:29]
L_fin:
L_end:
  s_endpgm
.section .rodata,"a"
.p2align 6
.amdhsa_kernel concat_heads__gqa_block_cached__gqa_block_cached__decode_kernel
  .amdhsa_next_free_vgpr 256
  .amdhsa_next_free_sgpr 70
  .amdhsa_accum_offset 256
  .amdhsa_group_segment_fixed_size 0
  .amdhsa_kernarg_size 104
  .amdhsa_user_sgpr_count 2
  .amdhsa_user_sgpr_kernarg_segment_ptr 1
  .amdhsa_system_sgpr_workgroup_id_x 1
.end_amdhsa_kernel
```
